```python
import torch

def _softmax(x, axis=-1):
    return torch.softmax(x, dim=axis)
def _gelu(x):
    return torch.nn.functional.gelu(x, approximate="tanh")
def _silu(x):
    return torch.nn.functional.silu(x)
def _sigmoid(x):
    return torch.sigmoid(x)
def _layernorm(x, axis=-1, eps=1e-5):
    m = x.mean(dim=axis, keepdim=True)
    v = x.var(dim=axis, keepdim=True, unbiased=False)
    return (x - m) / torch.sqrt(v + eps)
def _scatter_add(tgt, idx, src, axis=0):
    return tgt.clone().index_add_(axis, idx, src)
def _segment_sum(src, seg, n):
    out = torch.zeros((n,) + src.shape[1:], dtype=src.dtype)
    return out.index_add_(0, seg, src)
def _pad(x, pw):
    flat = tuple(v for pair in reversed(pw) for v in pair)
    return torch.nn.functional.pad(x, flat)

kernel_name = 'standalone__gqa_softmax__sampling'

def setup_inputs():

    _w = (lambda a: (lambda t: t.to(torch.bfloat16) if t.is_floating_point() else t)(torch.as_tensor(a)))
    B, Hq, Hkv, Sq, Sk, D = 16, 32, 8, 16, 2048, 128
    return {
        "q": _w((lambda *s: torch.randn(*s, dtype=torch.bfloat16) * 0.8)(B, Hq, Sq, D)),
        "k": _w((lambda *s: torch.randn(*s, dtype=torch.bfloat16) * 0.8)(B, Hkv, Sk, D)),
        "v": _w((lambda *s: torch.randn(*s, dtype=torch.bfloat16) * 0.05)(B, Hkv, Sk, D)),
    }

def reference(q, k, v):
    B, Hq, Sq, D = q.shape
    Hkv = k.shape[1]
    rep = Hq // Hkv
    k = (lambda x, n, axis: torch.repeat_interleave(x, n, dim=axis))(k, rep, axis=1)
    v = (lambda x, n, axis: torch.repeat_interleave(x, n, dim=axis))(v, rep, axis=1)
    scale = D ** -0.5
    scores = torch.einsum("bhqd,bhkd->bhqk", q, k) * scale
    p = _softmax(scores, axis=-1)
    return torch.einsum("bhqk,bhkd->bhqd", p, v)
```

```asm
; @launch grid=(256,1,1) block=(384,1,1) lds=159744
.amdgcn_target "amdgcn-amd-amdhsa--gfx950"
.text
.globl standalone__gqa_softmax__sampling_kernel
.p2align 8
.type standalone__gqa_softmax__sampling_kernel,@function
standalone__gqa_softmax__sampling_kernel:
  s_cmp_ge_u32 s2, 256
  s_cbranch_scc1 L_end
  s_load_dwordx8 s[4:11], s[0:1], 0
  s_load_dwordx4 s[12:15], s[0:1], 32
  v_lshrrev_b32 v1, 6, v0
  v_and_b32 v0, 63, v0
  v_readfirstlane_b32 s3, v1
  s_and_b32 s32, s2, 7
  s_lshl_b32 s32, s32, 4
  s_lshr_b32 s33, s2, 4
  s_add_u32 s32, s32, s33
  s_and_b32 s33, s2, 8
  s_lshl_b32 s33, s33, 4
  v_and_b32 v2, 15, v0
  v_lshrrev_b32 v3, 4, v0
  s_mov_b32 s19, 0x00020000
  s_mov_b32 s23, 0x00020000
  s_mov_b32 s40, 131072
  v_lshl_add_u32 v16, v0, 3, s40
  v_and_b32 v5, 3, v0
  v_mul_u32_u24 v5, 260, v5
  v_add_u32 v17, 131584, v5
  v_mov_b32 v18, 0
  v_mov_b32 v19, 0
  ds_write_b64 v16, v[18:19]
  ds_write_b32 v17, v19
  ds_write_b32 v17, v19 offset:1280
  v_lshlrev_b32 v4, 8, v3
  v_add_u32 v5, 0, v3
  v_xor_b32 v5, v5, v2
  v_lshl_add_u32 v8, v5, 4, v4
  v_add_u32 v5, 4, v3
  v_xor_b32 v5, v5, v2
  v_lshl_add_u32 v9, v5, 4, v4
  v_add_u32 v5, 8, v3
  v_xor_b32 v5, v5, v2
  v_lshl_add_u32 v10, v5, 4, v4
  v_add_u32 v5, 12, v3
  v_xor_b32 v5, v5, v2
  v_lshl_add_u32 v11, v5, 4, v4
  v_lshrrev_b32 v4, 3, v0
  v_lshlrev_b32 v4, 8, v4
  v_and_b32 v5, 7, v0
  v_lshlrev_b32 v6, 1, v3
  v_xor_b32 v6, v5, v6
  v_lshl_add_u32 v12, v6, 4, v4
  v_add_u32 v13, 1024, v12
  v_add_u32 v14, 2048, v12
  v_add_u32 v15, 3072, v12
  s_lshl_b32 s39, s32, 19
  s_lshl_b32 s41, s33, 11
  s_add_u32 s39, s39, s41
  s_mov_b32 s18, 0x40000
  s_mov_b32 s36, 0
  s_mov_b32 s37, 0
  s_mov_b32 s41, 0
  s_mov_b32 s42, 4096
  s_mov_b32 s46, 4096
  s_mov_b32 s43, 32
  s_cmp_lg_u32 s3, 0
  s_waitcnt lgkmcnt(0)
  s_barrier
  s_cbranch_scc1 L_notloader
  s_setprio 3
  s_add_u32 s16, s6, s39
  s_addc_u32 s17, s7, 0
  s_and_b32 s17, s17, 0xffff
  s_mov_b32 s47, 0
L_lloopw18:
  s_sub_u32 s44, s36, 15
  s_sub_u32 s45, s36, 2
  s_max_i32 s45, s45, s47
L_crw18:
  s_waitcnt lgkmcnt(0)
  v_cmp_gt_i32 vcc, s44, v19
  s_cbranch_vccnz L_crww18
  s_mov_b32 m0, s37
  s_add_u32 s37, s37, 4096
  s_waitcnt vmcnt(18)
  buffer_load_dwordx4 v8, s[16:19], s41 offen offset:0 nt lds
  buffer_load_dwordx4 v9, s[16:19], s41 offen offset:1024 nt lds
  s_waitcnt vmcnt(18)
  v_mov_b32 v18, s45
  ds_write_b32 v16, v18
  buffer_load_dwordx4 v10, s[16:19], s41 offen offset:2048 nt lds
  buffer_load_dwordx4 v11, s[16:19], s41 offen offset:3072 nt lds
  s_add_u32 s41, s41, s42
  ds_read_b32 v19, v17
  s_mov_b32 m0, s37
  s_add_u32 s37, s37, 4096
  s_waitcnt vmcnt(18)
  buffer_load_dwordx4 v8, s[16:19], s41 offen offset:0 nt lds
  buffer_load_dwordx4 v9, s[16:19], s41 offen offset:1024 nt lds
  s_waitcnt vmcnt(18)
  buffer_load_dwordx4 v10, s[16:19], s41 offen offset:2048 nt lds
  buffer_load_dwordx4 v11, s[16:19], s41 offen offset:3072 nt lds
  s_add_u32 s41, s41, s42
  s_and_b32 s37, s37, 131071
  s_add_u32 s36, s36, 1
  s_cmp_lg_u32 s36, s43
  s_cbranch_scc1 L_lloopw18
L_sw:
  s_mov_b32 s47, s45
  s_cmp_eq_u32 s36, 64
  s_cbranch_scc1 L_ltail
L_switchv:
  s_xor_b32 s33, s33, 128
  s_add_u32 s40, s33, s39
  s_add_u32 s16, s8, s40
  s_addc_u32 s17, s9, 0
  s_and_b32 s17, s17, 0xffff
  s_mov_b32 s18, 262016
  s_mov_b32 s41, 0
  s_mov_b32 s42, 8192
  s_add_u32 s43, s36, 16
  v_mov_b32 v8, v12
  v_mov_b32 v9, v13
  v_mov_b32 v10, v14
  v_mov_b32 v11, v15
  s_branch L_lloopw18
L_ltail:
  s_waitcnt vmcnt(16)
  v_mov_b32 v18, 62
  ds_write_b32 v16, v18
  s_waitcnt vmcnt(8)
  v_mov_b32 v18, 63
  ds_write_b32 v16, v18
  s_waitcnt vmcnt(0)
  v_mov_b32 v18, 64
  ds_write_b32 v16, v18
  s_endpgm
L_crww18:
  s_sleep 1
  ds_read_b32 v19, v17
  s_branch L_crw18
L_notloader:
  s_cmp_lg_u32 s3, 1
  s_cbranch_scc1 L_compute
  s_setprio 2
  s_lshl_b32 s41, s32, 14
  s_mov_b32 s18, 16384
  v_lshlrev_b32 v1, 4, v0
  s_add_u32 s16, s4, s41
  s_addc_u32 s17, s5, 0
  s_lshr_b32 s40, s33, 7
  s_lshl_b32 s44, s32, 1
  s_add_u32 s44, s44, s40
  s_xor_b32 s45, s44, 1
  s_mul_i32 s28, s44, 9472
  s_mul_i32 s29, s45, 9472
  s_mov_b32 s20, s16
  s_and_b32 s21, s17, 0xffff
  s_mov_b32 s22, 16384
  s_mov_b32 m0, 134144
  s_mov_b32 s42, 0
  buffer_load_dwordx4 v12, s[20:23], s42 offen offset:0 nt lds
  buffer_load_dwordx4 v13, s[20:23], s42 offen offset:1024 nt lds
  s_mov_b32 m0, 136192
  s_mov_b32 s42, 128
  buffer_load_dwordx4 v12, s[20:23], s42 offen offset:0 nt lds
  buffer_load_dwordx4 v13, s[20:23], s42 offen offset:1024 nt lds
  s_mov_b32 m0, 138240
  s_mov_b32 s42, 4096
  buffer_load_dwordx4 v12, s[20:23], s42 offen offset:0 nt lds
  buffer_load_dwordx4 v13, s[20:23], s42 offen offset:1024 nt lds
  s_mov_b32 m0, 140288
  s_mov_b32 s42, 4224
  buffer_load_dwordx4 v12, s[20:23], s42 offen offset:0 nt lds
  buffer_load_dwordx4 v13, s[20:23], s42 offen offset:1024 nt lds
  s_mov_b32 m0, 142336
  s_mov_b32 s42, 8192
  buffer_load_dwordx4 v12, s[20:23], s42 offen offset:0 nt lds
  buffer_load_dwordx4 v13, s[20:23], s42 offen offset:1024 nt lds
  s_mov_b32 m0, 144384
  s_mov_b32 s42, 8320
  buffer_load_dwordx4 v12, s[20:23], s42 offen offset:0 nt lds
  buffer_load_dwordx4 v13, s[20:23], s42 offen offset:1024 nt lds
  s_mov_b32 m0, 146432
  s_mov_b32 s42, 12288
  buffer_load_dwordx4 v12, s[20:23], s42 offen offset:0 nt lds
  buffer_load_dwordx4 v13, s[20:23], s42 offen offset:1024 nt lds
  s_mov_b32 m0, 148480
  s_mov_b32 s42, 12416
  buffer_load_dwordx4 v12, s[20:23], s42 offen offset:0 nt lds
  buffer_load_dwordx4 v13, s[20:23], s42 offen offset:1024 nt lds
L_hx:
  s_getpc_b64 s[52:53]
L_pc:
  s_sub_u32 s52, s52, L_pc-standalone__gqa_softmax__sampling_kernel
  s_subb_u32 s53, s53, 0
  s_lshr_b32 s40, s2, 3
  s_lshl_b32 s40, s40, 7
  s_add_u32 s40, s40, 1280
  s_min_u32 s40, s40, L_codeend-standalone__gqa_softmax__sampling_kernel-4
  s_load_dword s54, s[52:53], s40
  s_add_u32 s30, s28, 4096
  s_add_u32 s31, s29, 4096
  s_add_u32 s34, s28, 8192
  s_add_u32 s35, s29, 8192
  v_add_u32 v2, 150528, v1
  v_lshlrev_b32 v3, 2, v0
  s_mov_b32 s24, s14
  s_and_b32 s25, s15, 0xffff
  s_mov_b32 s26, 0x10000000
  s_mov_b32 s27, 0x00020000
  s_add_u32 s64, s10, s41
  s_addc_u32 s65, s11, 0
  s_and_b32 s65, s65, 0xffff
  s_mov_b32 s66, 16384
  s_mov_b32 s67, 0x00020000
  s_add_u32 s72, s33, 0
  s_xor_b32 s68, s72, 128
  s_add_u32 s73, s33, 4096
  s_xor_b32 s69, s73, 128
  s_add_u32 s74, s33, 8192
  s_xor_b32 s70, s74, 128
  s_add_u32 s75, s33, 12288
  s_xor_b32 s71, s75, 128
  v_mov_b32 v18, 1
  s_waitcnt vmcnt(0)
  ds_write_b32 v16, v18 offset:4
  s_setprio 0
L_hwt:
  s_sleep 8
  ds_read_b32 v19, v17 offset:0
  s_waitcnt lgkmcnt(0)
  v_cmp_gt_i32 vcc, 4, v19
  s_cbranch_vccnz L_hwt
  s_load_dword s57, s[8:9], s39
  s_load_dword s58, s[14:15], s28
  s_load_dword s59, s[64:65], s68
  s_waitcnt lgkmcnt(0)
  buffer_load_dword v8, off, s[24:27], s35 offset:1024 sc1
  buffer_load_dword v7, off, s[24:27], s35 offset:1156 sc1
  s_getreg_b32 s56, hwreg(HW_REG_XCC_ID, 0, 4)
  v_cmp_eq_u32 vcc, 0, v0
  s_waitcnt vmcnt(0)
  v_add_u32 v8, 1, v8
  v_lshl_or_b32 v5, v8, 4, s56
  v_cndmask_b32 v6, v5, v8, vcc
L_hwu:
  s_sleep 8
  ds_read_b32 v19, v17 offset:0
  s_waitcnt lgkmcnt(0)
  v_cmp_gt_i32 vcc, 10, v19
  s_cbranch_vccnz L_hwu
  s_mov_b32 exec_hi, 0
  buffer_store_dword v6, v3, s[24:27], s34 offen offset:1152 sc1
  s_mov_b32 exec_hi, -1
L_hwa:
  s_sleep 8
  ds_read_b32 v19, v17 offset:0
  s_waitcnt lgkmcnt(0)
  v_cmp_gt_i32 vcc, 24, v19
  s_cbranch_vccnz L_hwa
  buffer_load_dwordx2 v[14:15], off, s[24:27], s35 offset:1152 sc1
L_hwb:
  s_sleep 8
  ds_read_b32 v19, v17 offset:0
  s_waitcnt lgkmcnt(0)
  v_cmp_gt_i32 vcc, 44, v19
  s_cbranch_vccnz L_hwb
  s_waitcnt vmcnt(0)
  v_mov_b32 v9, v14
  v_readfirstlane_b32 s57, v15
  v_readfirstlane_b32 s58, v7
  s_and_b32 s59, s57, 15
  s_cmp_eq_u32 s57, s58
  s_cselect_b32 s59, 16, s59
L_hwc:
  s_sleep 1
  ds_read_b32 v19, v17 offset:1280
  s_waitcnt lgkmcnt(0)
  v_cmp_gt_i32 vcc, 1, v19
  s_cbranch_vccnz L_hwc
  ds_read_b128 v[20:23], v2 offset:0
  ds_read_b128 v[24:27], v2 offset:1024
  ds_read_b128 v[28:31], v2 offset:2048
  ds_read_b128 v[32:35], v2 offset:3072
  ds_read_b128 v[36:39], v2 offset:4096
  ds_read_b128 v[40:43], v2 offset:5120
  ds_read_b128 v[44:47], v2 offset:6144
  ds_read_b128 v[48:51], v2 offset:7168
  ds_read_b128 v[52:55], v2 offset:8192
  s_cmp_lg_u32 s59, s56
  s_cbranch_scc1 L_far
  s_waitcnt lgkmcnt(8)
  buffer_store_dwordx4 v[20:23], v12, s[64:67], s68 offen offset:0
  s_waitcnt lgkmcnt(7)
  buffer_store_dwordx4 v[24:27], v13, s[64:67], s68 offen offset:1024
  s_waitcnt lgkmcnt(6)
  buffer_store_dwordx4 v[28:31], v12, s[64:67], s69 offen offset:0
  s_waitcnt lgkmcnt(5)
  buffer_store_dwordx4 v[32:35], v13, s[64:67], s69 offen offset:1024
  s_waitcnt lgkmcnt(4)
  buffer_store_dwordx4 v[36:39], v12, s[64:67], s70 offen offset:0
  s_waitcnt lgkmcnt(3)
  buffer_store_dwordx4 v[40:43], v13, s[64:67], s70 offen offset:1024
  s_waitcnt lgkmcnt(2)
  buffer_store_dwordx4 v[44:47], v12, s[64:67], s71 offen offset:0
  s_waitcnt lgkmcnt(1)
  buffer_store_dwordx4 v[48:51], v13, s[64:67], s71 offen offset:1024
  s_waitcnt lgkmcnt(0)
  buffer_store_dwordx4 v[52:55], v1, s[24:27], s34 offen offset:0
L_sent:
  s_waitcnt vmcnt(0)
  s_mov_b32 exec_hi, 0
  buffer_store_dword v9, v3, s[24:27], s34 offen offset:1024 sc1
  s_mov_b32 exec_hi, -1
L_hwd:
  s_sleep 2
  ds_read_b32 v19, v17 offset:0
  s_waitcnt lgkmcnt(0)
  v_cmp_gt_i32 vcc, 55, v19
  s_cbranch_vccnz L_hwd
L_hpoll:
  buffer_load_dword v10, off, s[24:27], s35 offset:1024 sc1
L_hpollw:
  s_waitcnt vmcnt(0)
  v_cmp_eq_u32 vcc, v8, v10
  s_cbranch_vccz L_hretry
  buffer_load_dwordx4 v[56:59], v1, s[24:27], s35 offen sc1
  buffer_load_dwordx4 v[20:23], v12, s[64:67], s72 offen offset:0 sc1
  buffer_load_dwordx4 v[24:27], v13, s[64:67], s72 offen offset:1024 sc1
  buffer_load_dwordx4 v[28:31], v12, s[64:67], s73 offen offset:0 sc1
  buffer_load_dwordx4 v[32:35], v13, s[64:67], s73 offen offset:1024 sc1
  buffer_load_dwordx4 v[36:39], v12, s[64:67], s74 offen offset:0 sc1
  buffer_load_dwordx4 v[40:43], v13, s[64:67], s74 offen offset:1024 sc1
  buffer_load_dwordx4 v[44:47], v12, s[64:67], s75 offen offset:0 sc1
  buffer_load_dwordx4 v[48:51], v13, s[64:67], s75 offen offset:1024 sc1
  buffer_load_dword v11, off, s[24:27], s35 offset:1152 sc1
  s_waitcnt vmcnt(9)
  v_min_f32 v4, v52, v56
  v_sub_f32 v5, v4, v52
  v_sub_f32 v6, v4, v56
  v_exp_f32 v5, v5
  v_exp_f32 v6, v6
  v_mul_f32 v4, v53, v5
  v_fma_f32 v4, v57, v6, v4
  v_rcp_f32 v4, v4
  s_nop 0
  v_mul_f32 v12, v5, v4
  v_mul_f32 v6, v6, v4
  v_ldexp_f32 v13, v6, v58
  ds_write_b64 v2, v[12:13] offset:8192
  s_waitcnt vmcnt(8)
  ds_write_b128 v2, v[20:23] offset:0
  s_waitcnt vmcnt(7)
  ds_write_b128 v2, v[24:27] offset:1024
  s_waitcnt vmcnt(6)
  ds_write_b128 v2, v[28:31] offset:2048
  s_waitcnt vmcnt(5)
  ds_write_b128 v2, v[32:35] offset:3072
  s_waitcnt vmcnt(4)
  ds_write_b128 v2, v[36:39] offset:4096
  s_waitcnt vmcnt(3)
  ds_write_b128 v2, v[40:43] offset:5120
  s_waitcnt vmcnt(2)
  ds_write_b128 v2, v[44:47] offset:6144
  s_waitcnt vmcnt(1)
  ds_write_b128 v2, v[48:51] offset:7168
  v_mov_b32 v13, 2
  s_waitcnt lgkmcnt(0)
  ds_write_b32 v16, v13 offset:4
  s_waitcnt vmcnt(0)
  v_cmp_eq_u32 vcc, v9, v11
  s_cbranch_vccnz L_end
  s_mov_b32 exec_hi, 0
  buffer_store_dword v11, v3, s[24:27], s34 offen offset:1024 sc1
  s_mov_b32 exec_hi, -1
  s_endpgm
L_far:
  s_waitcnt lgkmcnt(8)
  buffer_store_dwordx4 v[20:23], v12, s[64:67], s68 offen offset:0 sc1
  s_waitcnt lgkmcnt(7)
  buffer_store_dwordx4 v[24:27], v13, s[64:67], s68 offen offset:1024 sc1
  s_waitcnt lgkmcnt(6)
  buffer_store_dwordx4 v[28:31], v12, s[64:67], s69 offen offset:0 sc1
  s_waitcnt lgkmcnt(5)
  buffer_store_dwordx4 v[32:35], v13, s[64:67], s69 offen offset:1024 sc1
  s_waitcnt lgkmcnt(4)
  buffer_store_dwordx4 v[36:39], v12, s[64:67], s70 offen offset:0 sc1
  s_waitcnt lgkmcnt(3)
  buffer_store_dwordx4 v[40:43], v13, s[64:67], s70 offen offset:1024 sc1
  s_waitcnt lgkmcnt(2)
  buffer_store_dwordx4 v[44:47], v12, s[64:67], s71 offen offset:0 sc1
  s_waitcnt lgkmcnt(1)
  buffer_store_dwordx4 v[48:51], v13, s[64:67], s71 offen offset:1024 sc1
  s_waitcnt lgkmcnt(0)
  buffer_store_dwordx4 v[52:55], v1, s[24:27], s34 offen offset:0 sc1
  s_branch L_sent
L_hretry:
  s_sleep 2
  buffer_load_dword v11, off, s[24:27], s35 offset:1152 sc1
  buffer_load_dword v10, off, s[24:27], s35 offset:1024 sc1
  s_waitcnt vmcnt(1)
  v_cmp_eq_u32 vcc, v9, v11
  s_cbranch_vccnz L_hpollw
  v_mov_b32 v9, v11
  s_mov_b32 exec_hi, 0
  buffer_store_dword v9, v3, s[24:27], s34 offen offset:1024 sc1
  s_mov_b32 exec_hi, -1
  s_branch L_hpollw
L_compute:
  s_sub_u32 s34, s3, 2
  s_lshl_b32 s38, s32, 14
  s_lshl_b32 s39, s34, 12
  s_add_u32 s38, s38, s39
  s_add_u32 s41, s38, s33
  v_lshlrev_b32 v4, 8, v2
  v_and_b32 v6, 1, v3
  v_lshl_add_u32 v11, v6, 5, v4
  v_lshrrev_b32 v6, 1, v3
  v_lshl_add_u32 v11, v6, 4, v11
  s_mov_b32 s22, 0x200000
  s_mov_b32 s50, 0x3e0293ee
  s_mov_b32 s40, 0x427af233
  s_mov_b32 s35, 0
  v_add_u32 v6, 0, v3
  v_xor_b32 v6, v6, v2
  v_lshl_add_u32 v32, v6, 4, v4
  v_add_u32 v6, 4, v3
  v_xor_b32 v6, v6, v2
  v_lshl_add_u32 v33, v6, 4, v4
  v_add_u32 v6, 8, v3
  v_xor_b32 v6, v6, v2
  v_lshl_add_u32 v34, v6, 4, v4
  v_add_u32 v6, 12, v3
  v_xor_b32 v6, v6, v2
  v_lshl_add_u32 v35, v6, 4, v4
  v_lshrrev_b32 v6, 2, v0
  v_and_b32 v7, 3, v0
  v_lshlrev_b32 v7, 3, v7
  v_lshl_add_u32 v7, v6, 7, v7
  v_bfe_u32 v6, v0, 3, 2
  v_xor_b32 v5, 0, v6
  v_lshl_add_u32 v40, v5, 5, v7
  v_xor_b32 v5, 1, v6
  v_lshl_add_u32 v41, v5, 5, v7
  v_xor_b32 v5, 2, v6
  v_lshl_add_u32 v42, v5, 5, v7
  v_xor_b32 v5, 3, v6
  v_lshl_add_u32 v43, v5, 5, v7
  v_bfe_u32 v6, v0, 1, 2
  v_lshlrev_b32 v6, 1, v6
  v_xor_b32 v6, v6, v3
  v_lshlrev_b32 v7, 7, v2
  v_lshl_add_u32 v36, v6, 4, v7
  s_add_u32 s44, s39, 134144
  v_add_u32 v36, s44, v36
  v_xor_b32 v37, 64, v36
  v_lshl_add_u32 v15, v0, 2, s44
  s_lshl_b32 s39, s34, 11
  s_add_u32 s44, s39, 150528
  v_lshl_add_u32 v1, v0, 4, s44
  s_lshl_b32 s39, s34, 8
  s_add_u32 s39, s39, 158720
  v_lshl_add_u32 v2, v2, 4, s39
  s_mov_b32 s39, 131072
  v_lshl_add_u32 v14, v0, 3, s39
  s_mul_i32 s39, s34, 260
  s_add_u32 s39, s39, 131584
  v_lshl_add_u32 v3, v0, 2, s39
  v_mov_b32 v44, 0
  v_mov_b32 v48, 0x3f803f80
  v_mov_b32 v45, 0
  v_mov_b32 v49, 0x3f803f80
  v_mov_b32 v46, 0
  v_mov_b32 v50, 0x3f803f80
  v_mov_b32 v47, 0
  v_mov_b32 v51, 0x3f803f80
  v_mov_b32 v8, 0xff800000
  v_mov_b32 v9, 0xff800000
  v_mov_b32 v10, 0x7f800000
  s_mov_b32 s36, 0
  s_mov_b32 s43, 0
  s_mov_b32 s46, 0
  s_mov_b32 s48, 2
  s_mov_b32 s54, 0
  s_mov_b32 s20, s10
  s_and_b32 s21, s11, 0xffff
L_wq:
  s_sleep 1
  ds_read_b32 v7, v14 offset:4
  s_waitcnt lgkmcnt(0)
  v_cmp_eq_u32 vcc, 0, v7
  s_cbranch_vccnz L_wq
  ds_read_b128 v[16:19], v36 offset:0
  ds_read_b128 v[20:23], v37 offset:0
  ds_read_b128 v[24:27], v36 offset:2048
  ds_read_b128 v[28:31], v37 offset:2048
  s_waitcnt lgkmcnt(0)
L_cloop:
  v_add_u32 v36, s43, v32
  v_add_u32 v37, s43, v33
  v_add_u32 v38, s43, v34
  v_add_u32 v39, s43, v35
  s_cmp_ge_u32 s54, s48
  s_cbranch_scc1 L_wdt
L_wpt:
  ds_read_b64 v[6:7], v14
  s_waitcnt lgkmcnt(0)
  v_readfirstlane_b32 s54, v6
  s_cmp_ge_u32 s54, s48
  s_cbranch_scc1 L_wdt
  s_sleep 1
  s_branch L_wpt
L_wdt:
  ds_read_b128 v[68:71], v36 offset:0
  ds_read_b128 v[72:75], v37 offset:0
  ds_read_b128 v[76:79], v38 offset:0
  ds_read_b128 v[80:83], v39 offset:0
  ds_read_b128 v[84:87], v36 offset:4096
  ds_read_b128 v[88:91], v37 offset:4096
  ds_read_b128 v[92:95], v38 offset:4096
  ds_read_b128 v[96:99], v39 offset:4096
  ds_read_b128 v[100:103], v36 offset:8192
  ds_read_b128 v[104:107], v37 offset:8192
  ds_read_b128 v[108:111], v38 offset:8192
  ds_read_b128 v[112:115], v39 offset:8192
  ds_read_b128 v[116:119], v36 offset:12288
  ds_read_b128 v[120:123], v37 offset:12288
  v_mov_b32 v13, s48
  s_add_u32 s43, s43, 16384
  s_and_b32 s43, s43, 131071
  s_waitcnt lgkmcnt(12)
  v_mfma_f32_16x16x32_bf16 v[52:55], v[68:71], v[16:19], 0
  ds_read_b128 v[124:127], v38 offset:12288
  v_mfma_f32_16x16x32_bf16 v[52:55], v[72:75], v[20:23], v[52:55]
  ds_read_b128 v[68:71], v39 offset:12288
  s_waitcnt lgkmcnt(12)
  v_mfma_f32_16x16x32_bf16 v[52:55], v[76:79], v[24:27], v[52:55]
  v_mfma_f32_16x16x32_bf16 v[52:55], v[80:83], v[28:31], v[52:55]
  s_waitcnt lgkmcnt(10)
  v_mfma_f32_16x16x32_bf16 v[56:59], v[84:87], v[16:19], 0
  v_mfma_f32_16x16x32_bf16 v[56:59], v[88:91], v[20:23], v[56:59]
  s_waitcnt lgkmcnt(8)
  v_mfma_f32_16x16x32_bf16 v[56:59], v[92:95], v[24:27], v[56:59]
  v_mfma_f32_16x16x32_bf16 v[56:59], v[96:99], v[28:31], v[56:59]
  s_waitcnt lgkmcnt(6)
  v_mfma_f32_16x16x32_bf16 v[60:63], v[100:103], v[16:19], 0
  v_mfma_f32_16x16x32_bf16 v[60:63], v[104:107], v[20:23], v[60:63]
  s_waitcnt lgkmcnt(4)
  v_mfma_f32_16x16x32_bf16 v[60:63], v[108:111], v[24:27], v[60:63]
  v_max3_f32 v4, v52, v53, v54
  v_mfma_f32_16x16x32_bf16 v[60:63], v[112:115], v[28:31], v[60:63]
  s_waitcnt lgkmcnt(2)
  v_mfma_f32_16x16x32_bf16 v[64:67], v[116:119], v[16:19], 0
  v_mfma_f32_16x16x32_bf16 v[64:67], v[120:123], v[20:23], v[64:67]
  v_max3_f32 v5, v55, v56, v57
  s_waitcnt lgkmcnt(0)
  v_mfma_f32_16x16x32_bf16 v[64:67], v[124:127], v[24:27], v[64:67]
  ds_write_b32 v3, v13
  v_max3_f32 v4, v4, v58, v59
  v_mfma_f32_16x16x32_bf16 v[64:67], v[68:71], v[28:31], v[64:67]
  v_max_f32 v4, v4, v5
  s_add_u32 s48, s48, 2
  v_max3_f32 v5, v60, v61, v62
  v_max3_f32 v4, v4, v5, v63
  s_nop 3
  v_max3_f32 v5, v64, v65, v66
  v_max3_f32 v4, v4, v5, v67
  v_cmp_gt_f32 vcc, v4, v9
  s_cbranch_vccnz L_newmax
L_maxok:
  v_fma_f32 v52, v52, s50, v10
  v_fma_f32 v53, v53, s50, v10
  v_exp_f32 v52, v52
  v_fma_f32 v54, v54, s50, v10
  v_exp_f32 v53, v53
  v_fma_f32 v55, v55, s50, v10
  v_exp_f32 v54, v54
  v_fma_f32 v56, v56, s50, v10
  v_exp_f32 v55, v55
  v_fma_f32 v57, v57, s50, v10
  v_exp_f32 v56, v56
  v_fma_f32 v58, v58, s50, v10
  v_exp_f32 v57, v57
  v_fma_f32 v59, v59, s50, v10
  v_exp_f32 v58, v58
  v_fma_f32 v60, v60, s50, v10
  v_exp_f32 v59, v59
  ds_read_b64 v[6:7], v14
  v_fma_f32 v61, v61, s50, v10
  v_exp_f32 v60, v60
  v_fma_f32 v62, v62, s50, v10
  v_exp_f32 v61, v61
  v_fma_f32 v63, v63, s50, v10
  v_exp_f32 v62, v62
  v_fma_f32 v64, v64, s50, v10
  v_exp_f32 v63, v63
  v_fma_f32 v65, v65, s50, v10
  v_exp_f32 v64, v64
  v_fma_f32 v66, v66, s50, v10
  v_exp_f32 v65, v65
  v_fma_f32 v67, v67, s50, v10
  v_exp_f32 v66, v66
  v_exp_f32 v67, v67
  s_set_gpr_idx_on s46, gpr_idx(DST)
  s_add_u32 s36, s36, 1
  v_cvt_pk_bf16_f32 v128, v52, v53
  v_cvt_pk_bf16_f32 v129, v54, v55
  v_cvt_pk_bf16_f32 v130, v56, v57
  v_cvt_pk_bf16_f32 v131, v58, v59
  v_cvt_pk_bf16_f32 v132, v60, v61
  v_cvt_pk_bf16_f32 v133, v62, v63
  v_cvt_pk_bf16_f32 v134, v64, v65
  v_cvt_pk_bf16_f32 v135, v66, v67
  s_set_gpr_idx_mode gpr_idx(SRC1)
  s_waitcnt lgkmcnt(0)
  v_readfirstlane_b32 s54, v6
  v_mfma_f32_16x16x32_bf16 v[44:47], v[48:51], v[128:131], v[44:47]
  v_mfma_f32_16x16x32_bf16 v[44:47], v[48:51], v[132:135], v[44:47]
  s_set_gpr_idx_off
  s_add_u32 s46, s46, 8
  s_cmp_eq_u32 s36, 4
  s_cbranch_scc1 L_warm
  s_cmp_lt_u32 s36, 16
  s_cbranch_scc1 L_cloop
  s_bitset0_b32 s35, 0
  s_lshl_b32 s47, s35, 16
  s_or_b32 s35, s35, s47
  s_or_b32 s52, s35, 0xff010000
  s_mov_b32 s46, 0
  s_mov_b32 s48, 33
  s_mov_b32 s53, 0
  v_mov_b32 v36, v40
  v_mov_b32 v37, v41
  v_mov_b32 v38, v42
  v_mov_b32 v39, v43
  v_mov_b32 v68, 0
  v_mov_b32 v69, 0
  v_mov_b32 v70, 0
  v_mov_b32 v71, 0
  v_mov_b32 v72, 0
  v_mov_b32 v73, 0
  v_mov_b32 v74, 0
  v_mov_b32 v75, 0
  v_mov_b32 v76, 0
  v_mov_b32 v77, 0
  v_mov_b32 v78, 0
  v_mov_b32 v79, 0
  v_mov_b32 v80, 0
  v_mov_b32 v81, 0
  v_mov_b32 v82, 0
  v_mov_b32 v83, 0
  s_set_gpr_idx_on s46, gpr_idx(SRC1)
L_pv:
L_wpf:
  ds_read_b64 v[6:7], v14
  s_waitcnt lgkmcnt(0)
  v_readfirstlane_b32 s54, v6
  s_cmp_ge_u32 s54, s48
  s_cbranch_scc1 L_wdf
  s_branch L_wpf
L_wdf:
  ds_read_b64_tr_b16 v[84:85], v36 offset:0
  ds_read_b64_tr_b16 v[86:87], v36 offset:2048
  ds_read_b64_tr_b16 v[88:89], v36 offset:4096
  ds_read_b64_tr_b16 v[90:91], v36 offset:6144
  ds_read_b64_tr_b16 v[92:93], v37 offset:0
  ds_read_b64_tr_b16 v[94:95], v37 offset:2048
  ds_read_b64_tr_b16 v[96:97], v37 offset:4096
  ds_read_b64_tr_b16 v[98:99], v37 offset:6144
  ds_read_b64_tr_b16 v[100:101], v38 offset:0
  ds_read_b64_tr_b16 v[102:103], v38 offset:2048
  ds_read_b64_tr_b16 v[104:105], v38 offset:4096
  ds_read_b64_tr_b16 v[106:107], v38 offset:6144
  ds_read_b64_tr_b16 v[108:109], v39 offset:0
  ds_read_b64_tr_b16 v[110:111], v39 offset:2048
L_go:
  s_add_u32 s43, s43, 8192
  s_and_b32 s43, s43, 131071
  s_cmp_gt_u32 s54, s48
  s_cbranch_scc0 L_drain
  s_waitcnt lgkmcnt(12)
  v_mfma_f32_16x16x32_bf16 v[68:71], v[84:87], v[128:131], v[68:71]
  ds_read_b64_tr_b16 v[112:113], v39 offset:4096
  ds_read_b64_tr_b16 v[114:115], v39 offset:6144
  ds_read_b64 v[6:7], v14
  v_add_u32_e64 v36, v40, s43
  s_waitcnt lgkmcnt(12)
  v_mfma_f32_16x16x32_bf16 v[68:71], v[88:91], v[132:135], v[68:71]
  ds_read_b64_tr_b16 v[84:85], v36 offset:0
  ds_read_b64_tr_b16 v[86:87], v36 offset:2048
  v_add_u32_e64 v37, v41, s43
  s_waitcnt lgkmcnt(12)
  v_mfma_f32_16x16x32_bf16 v[72:75], v[92:95], v[128:131], v[72:75]
  ds_read_b64_tr_b16 v[88:89], v36 offset:4096
  ds_read_b64_tr_b16 v[90:91], v36 offset:6144
  v_add_u32_e64 v38, v42, s43
  s_waitcnt lgkmcnt(12)
  v_mfma_f32_16x16x32_bf16 v[72:75], v[96:99], v[132:135], v[72:75]
  ds_read_b64_tr_b16 v[92:93], v37 offset:0
  ds_read_b64_tr_b16 v[94:95], v37 offset:2048
  v_add_u32_e64 v39, v43, s43
  s_waitcnt lgkmcnt(12)
  v_mfma_f32_16x16x32_bf16 v[76:79], v[100:103], v[128:131], v[76:79]
  ds_read_b64_tr_b16 v[96:97], v37 offset:4096
  ds_read_b64_tr_b16 v[98:99], v37 offset:6144
  v_mov_b32 v13, s48
  s_waitcnt lgkmcnt(12)
  v_mfma_f32_16x16x32_bf16 v[76:79], v[104:107], v[132:135], v[76:79]
  ds_read_b64_tr_b16 v[100:101], v38 offset:0
  ds_read_b64_tr_b16 v[102:103], v38 offset:2048
  s_add_u32 s46, s46, 8
  s_and_b32 s46, s46, 127
  s_waitcnt lgkmcnt(12)
  v_mfma_f32_16x16x32_bf16 v[80:83], v[108:111], v[128:131], v[80:83]
  ds_read_b64_tr_b16 v[104:105], v38 offset:4096
  ds_read_b64_tr_b16 v[106:107], v38 offset:6144
  s_waitcnt lgkmcnt(12)
  v_mfma_f32_16x16x32_bf16 v[80:83], v[112:115], v[132:135], v[80:83]
  ds_read_b64_tr_b16 v[108:109], v39 offset:0
  ds_read_b64_tr_b16 v[110:111], v39 offset:2048
  v_readfirstlane_b32 s54, v6
  ds_write_b32 v3, v13
  s_set_gpr_idx_idx s46
  s_lshr_b32 s47, s52, s48
  s_add_u32 s48, s48, 1
  s_bitcmp0_b32 s47, 0
  s_cbranch_scc1 L_go
  s_mov_b32 s55, 1
  s_branch L_event
L_drain:
  s_waitcnt lgkmcnt(12)
  v_mfma_f32_16x16x32_bf16 v[68:71], v[84:87], v[128:131], v[68:71]
  ds_read_b64_tr_b16 v[112:113], v39 offset:4096
  ds_read_b64_tr_b16 v[114:115], v39 offset:6144
  s_waitcnt lgkmcnt(12)
  v_mfma_f32_16x16x32_bf16 v[68:71], v[88:91], v[132:135], v[68:71]
  v_add_u32_e64 v36, v40, s43
  s_waitcnt lgkmcnt(10)
  v_mfma_f32_16x16x32_bf16 v[72:75], v[92:95], v[128:131], v[72:75]
  v_add_u32_e64 v37, v41, s43
  s_waitcnt lgkmcnt(8)
  v_mfma_f32_16x16x32_bf16 v[72:75], v[96:99], v[132:135], v[72:75]
  v_add_u32_e64 v38, v42, s43
  s_waitcnt lgkmcnt(6)
  v_mfma_f32_16x16x32_bf16 v[76:79], v[100:103], v[128:131], v[76:79]
  v_add_u32_e64 v39, v43, s43
  s_waitcnt lgkmcnt(4)
  v_mfma_f32_16x16x32_bf16 v[76:79], v[104:107], v[132:135], v[76:79]
  v_mov_b32 v13, s48
  s_waitcnt lgkmcnt(2)
  v_mfma_f32_16x16x32_bf16 v[80:83], v[108:111], v[128:131], v[80:83]
  s_add_u32 s46, s46, 8
  s_and_b32 s46, s46, 127
  s_cmp_eq_u32 s48, 64
  s_waitcnt lgkmcnt(0)
  v_mfma_f32_16x16x32_bf16 v[80:83], v[112:115], v[132:135], v[80:83]
  s_cbranch_scc1 L_fin0
  ds_write_b32 v3, v13
  s_set_gpr_idx_idx s46
  s_lshr_b32 s47, s52, s48
  s_add_u32 s48, s48, 1
  s_bitcmp0_b32 s47, 0
  s_cbranch_scc1 L_pv
  s_mov_b32 s55, 0
L_event:
  s_set_gpr_idx_off
  s_cmp_eq_u32 s48, 49
  s_cbranch_scc1 L_send
  s_cmp_eq_u32 s53, 0
  s_cbranch_scc1 L_next
L_chk:
  v_readfirstlane_b32 s47, v7
  s_cmp_eq_u32 s47, 2
  s_cbranch_scc1 L_fac
  s_cmp_lt_u32 s48, 64
  s_cbranch_scc1 L_next
  s_sleep 1
  s_waitcnt lgkmcnt(0)
  ds_read_b64 v[6:7], v14
  s_waitcnt lgkmcnt(0)
  s_branch L_chk
L_next:
  s_sub_u32 s36, s48, 1
  s_bitcmp0_b32 s35, s36
  s_cbranch_scc1 L_back
  s_lshl_b32 s47, s46, 5
  v_add_u32 v4, s47, v15
  s_waitcnt lgkmcnt(0)
  ds_read_b32 v12, v4
  s_waitcnt lgkmcnt(0)
  v_pk_mul_f32 v[68:69], v[68:69], v[12:13] op_sel_hi:[1,0]
  v_pk_mul_f32 v[70:71], v[70:71], v[12:13] op_sel_hi:[1,0]
  v_pk_mul_f32 v[72:73], v[72:73], v[12:13] op_sel_hi:[1,0]
  v_pk_mul_f32 v[74:75], v[74:75], v[12:13] op_sel_hi:[1,0]
  v_pk_mul_f32 v[76:77], v[76:77], v[12:13] op_sel_hi:[1,0]
  v_pk_mul_f32 v[78:79], v[78:79], v[12:13] op_sel_hi:[1,0]
  v_pk_mul_f32 v[80:81], v[80:81], v[12:13] op_sel_hi:[1,0]
  v_pk_mul_f32 v[82:83], v[82:83], v[12:13] op_sel_hi:[1,0]
L_back:
  s_set_gpr_idx_on s46, gpr_idx(SRC1)
  s_cmp_eq_u32 s55, 0
  s_cbranch_scc1 L_pv
  s_branch L_go
L_send:
  v_max3_f32 v4, abs(v68), abs(v69), abs(v70)
  v_max3_f32 v4, v4, abs(v71), abs(v72)
  v_max3_f32 v4, v4, abs(v73), abs(v74)
  v_max3_f32 v4, v4, abs(v75), abs(v76)
  v_max3_f32 v4, v4, abs(v77), abs(v78)
  v_max3_f32 v4, v4, abs(v79), abs(v80)
  v_max3_f32 v4, v4, abs(v81), abs(v82)
  v_max_f32 v4, v4, abs(v83)
  v_mov_b32 v5, v4
  s_nop 1
  v_permlane16_swap_b32 v4, v5
  v_max_f32 v4, v4, v5
  v_mov_b32 v5, v4
  s_nop 1
  v_permlane32_swap_b32 v4, v5
  v_max_f32 v4, v4, v5
  v_frexp_exp_i32_f32 v4, v4
  v_subrev_u32 v34, 15, v4
  v_sub_u32 v5, 15, v4
  v_ldexp_f32 v68, v68, v5
  v_ldexp_f32 v69, v69, v5
  v_ldexp_f32 v70, v70, v5
  v_ldexp_f32 v71, v71, v5
  v_ldexp_f32 v72, v72, v5
  v_ldexp_f32 v73, v73, v5
  v_ldexp_f32 v74, v74, v5
  v_ldexp_f32 v75, v75, v5
  v_ldexp_f32 v76, v76, v5
  v_ldexp_f32 v77, v77, v5
  v_ldexp_f32 v78, v78, v5
  v_ldexp_f32 v79, v79, v5
  v_ldexp_f32 v80, v80, v5
  v_ldexp_f32 v81, v81, v5
  v_ldexp_f32 v82, v82, v5
  v_ldexp_f32 v83, v83, v5
  v_cvt_pk_f16_f32 v16, v68, v69
  v_cvt_pk_f16_f32 v17, v70, v71
  v_cvt_pk_f16_f32 v18, v72, v73
  v_cvt_pk_f16_f32 v19, v74, v75
  v_cvt_pk_f16_f32 v20, v76, v77
  v_cvt_pk_f16_f32 v21, v78, v79
  v_cvt_pk_f16_f32 v22, v80, v81
  v_cvt_pk_f16_f32 v23, v82, v83
  v_mov_b32 v32, v10
  v_mov_b32 v33, v44
  s_waitcnt lgkmcnt(0)
  ds_write_b128 v1, v[16:19] offset:0
  ds_write_b128 v1, v[20:23] offset:1024
  ds_write_b128 v2, v[32:35]
  ds_write_b32 v3, v13 offset:1280
  v_mov_b32 v68, 0
  v_mov_b32 v69, 0
  v_mov_b32 v70, 0
  v_mov_b32 v71, 0
  v_mov_b32 v72, 0
  v_mov_b32 v73, 0
  v_mov_b32 v74, 0
  v_mov_b32 v75, 0
  v_mov_b32 v76, 0
  v_mov_b32 v77, 0
  v_mov_b32 v78, 0
  v_mov_b32 v79, 0
  v_mov_b32 v80, 0
  v_mov_b32 v81, 0
  v_mov_b32 v82, 0
  v_mov_b32 v83, 0
  s_mov_b32 s53, 1
  s_cbranch_execnz L_back
L_fac:
  s_waitcnt lgkmcnt(0)
  ds_read_b64 v[8:9], v2
  ds_read_b128 v[24:27], v1 offset:0
  ds_read_b128 v[28:31], v1 offset:1024
  s_waitcnt lgkmcnt(0)
  v_fma_mix_f32 v52, v24, v9, 0 op_sel:[0,0,0] op_sel_hi:[1,0,0]
  v_fma_mix_f32 v53, v24, v9, 0 op_sel:[1,0,0] op_sel_hi:[1,0,0]
  v_fma_mix_f32 v54, v25, v9, 0 op_sel:[0,0,0] op_sel_hi:[1,0,0]
  v_fma_mix_f32 v55, v25, v9, 0 op_sel:[1,0,0] op_sel_hi:[1,0,0]
  v_fma_mix_f32 v56, v26, v9, 0 op_sel:[0,0,0] op_sel_hi:[1,0,0]
  v_fma_mix_f32 v57, v26, v9, 0 op_sel:[1,0,0] op_sel_hi:[1,0,0]
  v_fma_mix_f32 v58, v27, v9, 0 op_sel:[0,0,0] op_sel_hi:[1,0,0]
  v_fma_mix_f32 v59, v27, v9, 0 op_sel:[1,0,0] op_sel_hi:[1,0,0]
  v_fma_mix_f32 v60, v28, v9, 0 op_sel:[0,0,0] op_sel_hi:[1,0,0]
  v_fma_mix_f32 v61, v28, v9, 0 op_sel:[1,0,0] op_sel_hi:[1,0,0]
  v_fma_mix_f32 v62, v29, v9, 0 op_sel:[0,0,0] op_sel_hi:[1,0,0]
  v_fma_mix_f32 v63, v29, v9, 0 op_sel:[1,0,0] op_sel_hi:[1,0,0]
  v_fma_mix_f32 v64, v30, v9, 0 op_sel:[0,0,0] op_sel_hi:[1,0,0]
  v_fma_mix_f32 v65, v30, v9, 0 op_sel:[1,0,0] op_sel_hi:[1,0,0]
  v_fma_mix_f32 v66, v31, v9, 0 op_sel:[0,0,0] op_sel_hi:[1,0,0]
  v_fma_mix_f32 v67, v31, v9, 0 op_sel:[1,0,0] op_sel_hi:[1,0,0]
  s_mov_b32 s53, 0
  s_mov_b32 s52, s35
  s_cbranch_execnz L_next
L_fin0:
  s_set_gpr_idx_off
  s_nop 0
  v_fma_f32 v68, v68, v8, v52
  v_fma_f32 v69, v69, v8, v53
  v_fma_f32 v70, v70, v8, v54
  v_fma_f32 v71, v71, v8, v55
  v_fma_f32 v72, v72, v8, v56
  v_fma_f32 v73, v73, v8, v57
  v_fma_f32 v74, v74, v8, v58
  v_fma_f32 v75, v75, v8, v59
  v_cvt_pk_bf16_f32 v84, v68, v69
  v_cvt_pk_bf16_f32 v85, v70, v71
  v_cvt_pk_bf16_f32 v86, v72, v73
  v_cvt_pk_bf16_f32 v87, v74, v75
  s_nop 0
  v_permlane16_swap_b32 v84, v86
  v_permlane16_swap_b32 v85, v87
  buffer_store_dwordx4 v[84:87], v11, s[20:23], s41 offen offset:0
  v_fma_f32 v76, v76, v8, v60
  v_fma_f32 v77, v77, v8, v61
  v_fma_f32 v78, v78, v8, v62
  v_fma_f32 v79, v79, v8, v63
  v_fma_f32 v80, v80, v8, v64
  v_fma_f32 v81, v81, v8, v65
  v_fma_f32 v82, v82, v8, v66
  v_fma_f32 v83, v83, v8, v67
  v_cvt_pk_bf16_f32 v88, v76, v77
  v_cvt_pk_bf16_f32 v89, v78, v79
  v_cvt_pk_bf16_f32 v90, v80, v81
  v_cvt_pk_bf16_f32 v91, v82, v83
  s_nop 0
  v_permlane16_swap_b32 v88, v90
  v_permlane16_swap_b32 v89, v91
  buffer_store_dwordx4 v[88:91], v11, s[20:23], s41 offen offset:64
  s_cbranch_execz L_warmret
L_end:
  s_endpgm
L_warm:
  s_mov_b64 exec, 0
  s_branch L_send
L_warmret:
  s_mov_b64 exec, -1
  s_branch L_cloop
L_newmax:
  v_mov_b32 v5, v4
  s_nop 1
  v_permlane16_swap_b32 v4, v5
  v_max_f32 v4, v4, v5
  v_mov_b32 v5, v4
  s_nop 1
  v_permlane32_swap_b32 v4, v5
  v_max3_f32 v8, v4, v5, v8
  v_add_f32 v9, s40, v8
  v_mul_f32 v4, s50, v8
  v_sub_f32 v5, -v10, v4
  v_sub_f32 v10, 0, v4
  v_exp_f32 v12, v5
  s_lshl_b32 s47, s46, 5
  v_add_u32 v4, s47, v15
  s_bitset1_b32 s35, s36
  v_mul_f32 v44, v44, v12
  v_mul_f32 v45, v45, v12
  v_mul_f32 v46, v46, v12
  v_mul_f32 v47, v47, v12
  ds_write_b32 v4, v12
  s_branch L_maxok
L_codeend:
.section .rodata,"a"
.p2align 6
.amdhsa_kernel standalone__gqa_softmax__sampling_kernel
  .amdhsa_next_free_vgpr 256
  .amdhsa_next_free_sgpr 80
  .amdhsa_accum_offset 256
  .amdhsa_group_segment_fixed_size 0
  .amdhsa_kernarg_size 48
  .amdhsa_user_sgpr_count 2
  .amdhsa_user_sgpr_kernarg_segment_ptr 1
  .amdhsa_system_sgpr_workgroup_id_x 1
.end_amdhsa_kernel
```
